```python
import torch

def _softmax(x, axis=-1):
    return torch.softmax(x, dim=axis)
def _gelu(x):
    return torch.nn.functional.gelu(x, approximate="tanh")
def _silu(x):
    return torch.nn.functional.silu(x)
def _sigmoid(x):
    return torch.sigmoid(x)
def _layernorm(x, axis=-1, eps=1e-5):
    m = x.mean(dim=axis, keepdim=True)
    v = x.var(dim=axis, keepdim=True, unbiased=False)
    return (x - m) / torch.sqrt(v + eps)
def _scatter_add(tgt, idx, src, axis=0):
    return tgt.clone().index_add_(axis, idx, src)
def _segment_sum(src, seg, n):
    out = torch.zeros((n,) + src.shape[1:], dtype=src.dtype)
    return out.index_add_(0, seg, src)
def _pad(x, pw):
    flat = tuple(v for pair in reversed(pw) for v in pair)
    return torch.nn.functional.pad(x, flat)

kernel_name = 'standalone__normalfloat_lut_codebook_lookup__prompt'

def setup_inputs():

    _w = (lambda a: (lambda t: t.to(torch.bfloat16) if t.is_floating_point() else t)(torch.as_tensor(a)))
    B, S, D, F = 1, 2048, 576, 4608
    G = -1 if -1 > 0 else D
    D = (D // G) * G
    ng = D // G
    nf4 = torch.tensor([
        -1.0, -0.6961928009986877, -0.5250730514526367, -0.39491748809814453,
        -0.28444138169288635, -0.18477343022823334, -0.09105003625154495, 0.0,
        0.07958029955625534, 0.16093020141124725, 0.24611230194568634, 0.33791524171829224,
        0.44070982933044434, 0.5626170039176941, 0.7229568362236023, 1.0
    ], dtype=float)
    qw = torch.randint(0, 16, (D, F)).to(torch.int64)
    absmax = (torch.abs((lambda *s: torch.randn(*s, dtype=torch.bfloat16) * 0.05)(ng, F)) + 0.01).to(float)
    return {
        "x": _w((lambda *s: torch.randn(*s, dtype=torch.bfloat16) * 0.05)(B, S, D)),
        "qw": _w(qw),
        "codebook": _w(nf4),
        "absmax": _w(absmax),
    }

def reference(x, qw, codebook, absmax):
    B, S, D = x.shape
    ng, F = absmax.shape
    G = D // ng
    w_nf = codebook[qw]
    s = (lambda x, n, axis: torch.repeat_interleave(x, n, dim=axis))(absmax, G, axis=0)
    w = (lambda x, dt: x.to(dt))(w_nf * s, x.dtype)
    return torch.einsum("bsd,df->bsf", x, w)
```

```asm
; @launch grid=(252,1,1) block=(512,1,1) lds=155648
.amdgcn_target "amdgcn-amd-amdhsa--gfx950"
.text
.globl standalone__normalfloat_lut_codebook_lookup__prompt_kernel
.p2align 8
.type standalone__normalfloat_lut_codebook_lookup__prompt_kernel,@function
standalone__normalfloat_lut_codebook_lookup__prompt_kernel:
    s_cmp_ge_u32 s2, 252
    s_cbranch_scc1 L_exit
    s_load_dwordx4 s[20:23], s[0:1], 0
    s_load_dwordx4 s[24:27], s[0:1], 16
    s_load_dwordx2 s[28:29], s[0:1], 32
    v_lshrrev_b32 v1, 6, v0
    v_and_b32 v0, 63, v0
    s_and_b32 s30, s2, 7
    s_lshr_b32 s31, s2, 3
    v_readfirstlane_b32 s3, v1
    s_lshl_b32 s32, s30, 5
    s_sub_i32 s33, s30, 4
    s_max_i32 s33, s33, 0
    s_sub_u32 s32, s32, s33
    s_add_u32 s32, s32, s31
    s_mul_i32 s33, s32, 9363
    s_lshr_b32 s33, s33, 16
    s_mul_i32 s34, s33, 7
    s_sub_u32 s34, s32, s34
    s_mul_i32 s35, s34, 18
    s_min_u32 s36, s34, 2
    s_add_u32 s35, s35, s36
    s_cmp_lt_u32 s34, 2
    s_cselect_b32 s36, 19, 18
    s_mov_b32 s58, 0
    s_cmp_ge_u32 s3, 4
    s_cbranch_scc0 L_compute
L_helper:
    s_cmp_ge_u32 s3, 6
    s_cbranch_scc1 L_storer
    s_sub_u32 s37, s3, 4
    v_lshrrev_b32 v4, 5, v0
    v_mul_u32_u24 v4, 18432, v4
    v_and_b32 v5, 31, v0
    v_lshl_add_u32 v2, v5, 4, v4
    v_xor_b32 v5, 8, v5
    v_lshl_add_u32 v3, v5, 4, v4
    s_mul_i32 s40, s37, 294912
    s_lshl_b32 s38, s37, 13
    v_lshrrev_b32 v7, 3, v0
    v_lshrrev_b32 v8, 1, v7
    s_lshl_b32 s42, s37, 2
    v_add_u32 v8, s42, v8
    v_and_b32 v9, 7, v0
    v_xor_b32 v8, v8, v9
    v_mul_u32_u24 v7, 1152, v7
    v_lshl_add_u32 v6, v8, 4, v7
    s_mul_i32 s42, s37, 9216
    s_add_u32 s48, s42, 0
    s_add_u32 s49, s42, 128
    s_add_u32 s50, s42, 256
    s_add_u32 s51, s42, 384
    s_add_u32 s52, s42, 512
    s_add_u32 s53, s42, 640
    s_add_u32 s54, s42, 768
    s_add_u32 s55, s42, 896
    s_add_u32 s56, s42, 1024
    s_lshl_b32 s39, s37, 10
    s_add_u32 s39, s39, 8192
    s_mov_b32 s57, 0
    s_lshl_b32 s41, s33, 9
    s_sub_u32 s10, 10616832, s41
    s_mov_b32 s11, 0x20000
    s_mul_i32 s45, s35, 18432
    s_mul_i32 s6, s36, 18432
    s_mov_b32 s7, 0x20000
    s_add_u32 s38, s38, 8192
    s_mov_b32 s61, 0
    s_mov_b32 s46, 4
    s_waitcnt lgkmcnt(0)
    s_add_u32 s8, s22, s41
    s_addc_u32 s9, s23, 0
    s_and_b32 s9, s9, 0xffff
L_ldA:
    s_add_u32 m0, s38, s61
    s_mov_b32 s44, s40
    buffer_load_dwordx4 v2, s[8:11], s44 offen  lds
    s_add_u32 m0, m0, 1024
    s_add_u32 s44, s44, 36864
    buffer_load_dwordx4 v2, s[8:11], s44 offen  lds
    s_add_u32 m0, m0, 1024
    s_add_u32 s44, s44, 36864
    buffer_load_dwordx4 v2, s[8:11], s44 offen  lds
    s_add_u32 m0, m0, 1024
    s_add_u32 s44, s44, 36864
    buffer_load_dwordx4 v2, s[8:11], s44 offen  lds
    s_add_u32 m0, m0, 1024
    s_add_u32 s44, s44, 36864
    buffer_load_dwordx4 v3, s[8:11], s44 offen  lds
    s_add_u32 m0, m0, 1024
    s_add_u32 s44, s44, 36864
    buffer_load_dwordx4 v3, s[8:11], s44 offen  lds
    s_add_u32 m0, m0, 1024
    s_add_u32 s44, s44, 36864
    buffer_load_dwordx4 v3, s[8:11], s44 offen  lds
    s_add_u32 m0, m0, 1024
    s_add_u32 s44, s44, 36864
    buffer_load_dwordx4 v3, s[8:11], s44 offen  lds
    s_add_u32 s40, s40, 589824
    s_add_u32 s61, s61, 18432
    s_cmp_eq_u32 s61, 147456
    s_cselect_b32 s61, 0, s61
    s_sub_u32 s46, s46, 1
    s_cmp_lg_u32 s46, 0
    s_cbranch_scc1 L_ldA
    s_add_u32 s4, s20, s45
    s_addc_u32 s5, s21, 0
    s_and_b32 s5, s5, 0xffff
    s_mov_b32 s46, 14
L_ldW:
    s_waitcnt vmcnt(24)
    s_barrier
    s_add_u32 m0, s38, s61
    s_mov_b32 s44, s40
    buffer_load_dwordx4 v2, s[8:11], s44 offen  lds
    s_add_u32 m0, m0, 1024
    s_add_u32 s44, s44, 36864
    buffer_load_dwordx4 v2, s[8:11], s44 offen  lds
    s_add_u32 m0, m0, 1024
    s_add_u32 s44, s44, 36864
    buffer_load_dwordx4 v2, s[8:11], s44 offen  lds
    s_add_u32 m0, m0, 1024
    s_add_u32 s44, s44, 36864
    buffer_load_dwordx4 v2, s[8:11], s44 offen  lds
    s_add_u32 m0, m0, 1024
    s_add_u32 s44, s44, 36864
    buffer_load_dwordx4 v3, s[8:11], s44 offen  lds
    s_add_u32 m0, m0, 1024
    s_add_u32 s44, s44, 36864
    buffer_load_dwordx4 v3, s[8:11], s44 offen  lds
    s_add_u32 m0, m0, 1024
    s_add_u32 s44, s44, 36864
    buffer_load_dwordx4 v3, s[8:11], s44 offen  lds
    s_add_u32 m0, m0, 1024
    s_add_u32 s44, s44, 36864
    buffer_load_dwordx4 v3, s[8:11], s44 offen  lds
    s_add_u32 s40, s40, 589824
    s_add_u32 s61, s61, 18432
    s_cmp_eq_u32 s61, 147456
    s_cselect_b32 s61, 0, s61
    s_sub_u32 s46, s46, 1
    s_cmp_lg_u32 s46, 0
    s_cbranch_scc1 L_ldW
    s_mov_b32 s46, 19
L_ldX:
    s_waitcnt vmcnt(24)
    s_barrier
    s_add_u32 m0, s39, s61
    s_add_u32 s44, s48, s57
    buffer_load_dwordx4 v6, s[4:7], s44 offen  lds
    s_add_u32 m0, m0, 2048
    s_add_u32 s44, s49, s57
    buffer_load_dwordx4 v6, s[4:7], s44 offen  lds
    s_add_u32 m0, m0, 2048
    s_add_u32 s44, s50, s57
    buffer_load_dwordx4 v6, s[4:7], s44 offen  lds
    s_add_u32 m0, m0, 2048
    s_add_u32 s44, s51, s57
    buffer_load_dwordx4 v6, s[4:7], s44 offen  lds
    s_add_u32 m0, m0, 2048
    s_add_u32 s44, s52, s57
    buffer_load_dwordx4 v6, s[4:7], s44 offen  lds
    s_add_u32 m0, m0, 2048
    s_add_u32 s44, s53, s57
    buffer_load_dwordx4 v6, s[4:7], s44 offen  lds
    s_add_u32 m0, m0, 2048
    s_add_u32 s44, s54, s57
    buffer_load_dwordx4 v6, s[4:7], s44 offen  lds
    s_add_u32 m0, m0, 2048
    s_add_u32 s44, s55, s57
    buffer_load_dwordx4 v6, s[4:7], s44 offen  lds
    s_add_u32 m0, m0, 2048
    s_add_u32 s44, s56, s57
    buffer_load_dwordx4 v6, s[4:7], s44 offen  lds
    s_add_u32 s57, s57, 18432
    s_cmp_eq_u32 s57, s6
    s_cselect_b32 s57, 0, s57
    s_add_u32 s61, s61, 18432
    s_cmp_eq_u32 s61, 147456
    s_cselect_b32 s61, 0, s61
    s_sub_u32 s46, s46, 1
    s_cmp_lg_u32 s46, 0
    s_cbranch_scc1 L_ldX
    s_waitcnt vmcnt(27)
    s_barrier
    s_waitcnt vmcnt(18)
    s_barrier
    s_waitcnt vmcnt(9)
    s_barrier
    s_waitcnt vmcnt(0)
    s_barrier
    s_barrier
    s_cmp_eq_u32 s36, 19
    s_cbranch_scc0 L_ld_end
    s_barrier
L_ld_end:
    s_endpgm
L_storer:
    s_sub_u32 s37, s3, 6
    v_lshrrev_b32 v4, 5, v0
    v_mul_u32_u24 v4, 18432, v4
    v_and_b32 v5, 31, v0
    v_lshl_add_u32 v2, v5, 4, v4
    v_lshlrev_b32 v24, 4, v0
    s_waitcnt lgkmcnt(0)
    s_mov_b32 s4, s20
    s_and_b32 s5, s21, 0xffff
    s_mov_b32 s6, 2359296
    s_mov_b32 s7, 0x20000
    s_mul_i32 s41, s32, 9360
    s_mul_i32 s42, s37, 5120
    s_add_u32 s41, s41, s42
    v_add_u32 v25, 4096, v24
    buffer_load_dwordx4 v[60:63], v24, s[4:7], s41 offen offset:0
    buffer_load_dwordx4 v[64:67], v24, s[4:7], s41 offen offset:1024
    buffer_load_dwordx4 v[68:71], v24, s[4:7], s41 offen offset:2048
    buffer_load_dwordx4 v[72:75], v24, s[4:7], s41 offen offset:3072
    buffer_load_dwordx4 v[76:79], v25, s[4:7], s41 offen offset:0
    v_lshrrev_b32 v4, 4, v0
    s_lshl_b32 s38, s37, 3
    v_add_u32 v4, s38, v4
    v_and_b32 v5, 15, v0
    v_add_u32 v8, 0, v4
    v_xor_b32 v9, v5, v8
    v_lshlrev_b32 v9, 4, v9
    v_lshl_add_u32 v10, v8, 8, v9
    v_mul_u32_u24 v8, 9216, v8
    v_lshl_add_u32 v12, v5, 4, v8
    v_add_u32 v8, 4, v4
    v_xor_b32 v9, v5, v8
    v_lshlrev_b32 v9, 4, v9
    v_lshl_add_u32 v11, v8, 8, v9
    v_mul_u32_u24 v8, 9216, v8
    v_lshl_add_u32 v13, v5, 4, v8
    s_mul_i32 s39, s35, 147456
    s_lshl_b32 s38, s33, 8
    s_add_u32 s39, s39, s38
    s_add_u32 s12, s28, s39
    s_addc_u32 s13, s29, 0
    s_and_b32 s13, s13, 0xffff
    s_mul_i32 s14, s36, 147456
    s_sub_u32 s14, s14, s38
    s_mov_b32 s15, 0x20000
    s_mov_b32 s46, 21 - 0
L_stA:
    s_barrier
    s_sub_u32 s46, s46, 1
    s_cmp_lg_u32 s46, 0
    s_cbranch_scc1 L_stA
    s_mov_b32 s44, 0
    s_mul_i32 s47, s36, 147456
    s_mov_b32 s45, 0
    s_waitcnt vmcnt(0)
    s_sub_u32 s46, s36, 2
L_stB:
    s_barrier
    v_add_u32 v14, s45, v10
    v_add_u32 v15, s45, v11
    ds_read_b128 v[16:19], v14 offset:0
    ds_read_b128 v[20:23], v15 offset:0
    s_xor_b32 s45, s45, 4096
    s_waitcnt lgkmcnt(1)
    buffer_store_dwordx4 v[16:19], v12, s[12:15], s44 offen sc1
    s_waitcnt lgkmcnt(0)
    buffer_store_dwordx4 v[20:23], v13, s[12:15], s44 offen sc1
    s_add_u32 s44, s44, 147456
    s_cmp_eq_u32 s44, s47
    s_cselect_b32 s44, 0, s44
    s_sub_u32 s46, s46, 1
    s_cmp_lg_u32 s46, 0
    s_cbranch_scc1 L_stB
    s_barrier
    v_add_u32 v14, s45, v10
    v_add_u32 v15, s45, v11
    ds_read_b128 v[16:19], v14 offset:0
    ds_read_b128 v[20:23], v15 offset:0
    s_xor_b32 s45, s45, 4096
    s_waitcnt lgkmcnt(1)
    buffer_store_dwordx4 v[16:19], v12, s[12:15], s44 offen sc1
    s_waitcnt lgkmcnt(0)
    buffer_store_dwordx4 v[20:23], v13, s[12:15], s44 offen sc1
    s_add_u32 s44, s44, 147456
    s_cmp_eq_u32 s44, s47
    s_cselect_b32 s44, 0, s44
    v_add_u32 v14, s45, v10
    v_add_u32 v15, s45, v11
    ds_read_b128 v[16:19], v14 offset:0
    ds_read_b128 v[20:23], v15 offset:0
    s_xor_b32 s45, s45, 4096
    s_waitcnt lgkmcnt(1)
    buffer_store_dwordx4 v[16:19], v12, s[12:15], s44 offen sc1
    s_waitcnt lgkmcnt(0)
    buffer_store_dwordx4 v[20:23], v13, s[12:15], s44 offen sc1
    s_add_u32 s44, s44, 147456
    s_cmp_eq_u32 s44, s47
    s_cselect_b32 s44, 0, s44
    s_endpgm
L_compute:
    v_and_b32 v12, 15, v0
    v_lshrrev_b32 v13, 4, v0
    s_lshl_b32 s39, s3, 7
    v_lshl_add_u32 v15, v12, 3, s39
    v_and_b32 v14, 1, v13
    v_lshlrev_b32 v14, 7, v14
    v_xor_b32 v15, v15, v14
    v_lshl_add_u32 v2, v13, 12, v15
    v_add_u32 v2, 8192, v2
    v_add_u32 v3, 55296, v2
    v_add_u32 v4, 110592, v2
    v_lshrrev_b32 v14, 1, v12
    v_xor_b32 v14, v14, v13
    v_lshlrev_b32 v14, 4, v14
    v_and_b32 v15, 7, v12
    v_lshl_add_u32 v14, v15, 7, v14
    v_lshrrev_b32 v15, 3, v12
    v_lshl_add_u32 v14, v15, 10, v14
    v_add_u32 v5, 45056, v14
    v_xor_b32 v6, 64, v5
    v_add_u32 v8, 18432, v5
    v_add_u32 v9, 18432, v6
    s_lshl_b32 s39, s3, 2
    v_add_u32 v14, s39, v13
    v_xor_b32 v14, v14, v12
    v_lshlrev_b32 v14, 4, v14
    v_lshl_add_u32 v11, v12, 8, v14
    s_lshl_b32 s39, s3, 11
    v_and_b32 v14, 31, v0
    v_lshl_add_u32 v48, v14, 2, s39
    v_mov_b32 v49, v48
    v_lshrrev_b32 v15, 5, v0
    v_lshl_add_u32 v50, v15, 10, v48
    v_lshlrev_b32 v15, 4, v15
    v_lshlrev_b32 v14, 2, v12
    s_mov_b32 s50, 0x43000000
    s_mov_b32 s51, 0x43000000
    s_mov_b32 s52, 0x05040100
    s_mov_b32 s53, 0x07060302
    s_mov_b32 s18, 9216
    s_mov_b32 s19, 0x20000
    s_mov_b32 s6, 32
    s_mov_b32 s7, 0x20000
    s_lshl_b32 s38, s33, 8
    s_lshl_b32 s39, s3, 6
    s_add_u32 s38, s38, s39
    s_waitcnt lgkmcnt(0)
    s_mov_b32 s16, s26
    s_and_b32 s17, s27, 0xffff
    s_mov_b32 s4, s24
    s_and_b32 s5, s25, 0xffff
    buffer_load_dword v51, v14, s[16:19], s38 offen
    buffer_load_dwordx4 v[52:55], v15, s[4:7], 0 offen
    s_waitcnt lgkmcnt(0)
    s_barrier
    ds_read_b64 v[16:17], v2 offset:0
    ds_read_b64 v[18:19], v2 offset:512
    ds_read_b64 v[20:21], v2 offset:1024
    ds_read_b64 v[22:23], v2 offset:1536
    ds_read_b64 v[24:25], v2 offset:2048
    ds_read_b64 v[26:27], v2 offset:2560
    ds_read_b64 v[28:29], v2 offset:3072
    ds_read_b64 v[30:31], v2 offset:3584
    s_waitcnt vmcnt(0)
    v_lshlrev_b32 v56, 16, v51
    v_and_b32 v57, 0xffff0000, v51
    v_lshlrev_b32 v58, 16, v52
    v_and_b32 v59, 0xffff0000, v52
    v_mul_f32 v60, v58, v56
    v_mul_f32 v61, v58, v57
    v_cvt_pk_bf16_f32 v62, v60, v61
    ds_write_b32 v50, v62 offset:0
    v_mul_f32 v60, v59, v56
    v_mul_f32 v61, v59, v57
    v_cvt_pk_bf16_f32 v63, v60, v61
    ds_write_b32 v50, v63 offset:128
    v_lshlrev_b32 v58, 16, v53
    v_and_b32 v59, 0xffff0000, v53
    v_mul_f32 v60, v58, v56
    v_mul_f32 v61, v58, v57
    v_cvt_pk_bf16_f32 v62, v60, v61
    ds_write_b32 v50, v62 offset:256
    v_mul_f32 v60, v59, v56
    v_mul_f32 v61, v59, v57
    v_cvt_pk_bf16_f32 v63, v60, v61
    ds_write_b32 v50, v63 offset:384
    v_lshlrev_b32 v58, 16, v54
    v_and_b32 v59, 0xffff0000, v54
    v_mul_f32 v60, v58, v56
    v_mul_f32 v61, v58, v57
    v_cvt_pk_bf16_f32 v62, v60, v61
    ds_write_b32 v50, v62 offset:512
    v_mul_f32 v60, v59, v56
    v_mul_f32 v61, v59, v57
    v_cvt_pk_bf16_f32 v63, v60, v61
    ds_write_b32 v50, v63 offset:640
    v_lshlrev_b32 v58, 16, v55
    v_and_b32 v59, 0xffff0000, v55
    v_mul_f32 v60, v58, v56
    v_mul_f32 v61, v58, v57
    v_cvt_pk_bf16_f32 v62, v60, v61
    ds_write_b32 v50, v62 offset:768
    v_mul_f32 v60, v59, v56
    v_mul_f32 v61, v59, v57
    v_cvt_pk_bf16_f32 v63, v60, v61
    s_waitcnt lgkmcnt(11)
    ds_write_b32 v50, v63 offset:896
    s_barrier
    v_pk_fma_f32 v[16:17], v[16:17], s[50:51], v[48:49]
    v_pk_fma_f32 v[18:19], v[18:19], s[50:51], v[48:49]
    v_pk_fma_f32 v[20:21], v[20:21], s[50:51], v[48:49]
    ds_read_b32 v96, v16 offset:0
    ds_read_b32 v97, v17 offset:0
    ds_read_b64 v[32:33], v2 offset:18432
    v_pk_fma_f32 v[22:23], v[22:23], s[50:51], v[48:49]
    s_waitcnt lgkmcnt(11)
    ds_read_b32 v98, v18 offset:0
    ds_read_b32 v99, v19 offset:0
    ds_read_b64 v[34:35], v2 offset:18944
    v_pk_fma_f32 v[24:25], v[24:25], s[50:51], v[48:49]
    ds_read_b32 v100, v20 offset:0
    s_waitcnt lgkmcnt(11)
    ds_read_b32 v101, v21 offset:0
    ds_read_b64 v[36:37], v2 offset:19456
    v_pk_fma_f32 v[26:27], v[26:27], s[50:51], v[48:49]
    ds_read_b32 v102, v22 offset:0
    ds_read_b32 v103, v23 offset:0
    s_waitcnt lgkmcnt(11)
    ds_read_b64 v[38:39], v2 offset:19968
    v_pk_fma_f32 v[28:29], v[28:29], s[50:51], v[48:49]
    ds_read_b32 v104, v24 offset:0
    ds_read_b32 v105, v25 offset:0
    ds_read_b64 v[40:41], v2 offset:20480
    v_pk_fma_f32 v[30:31], v[30:31], s[50:51], v[48:49]
    s_waitcnt lgkmcnt(11)
    ds_read_b32 v106, v26 offset:0
    ds_read_b32 v107, v27 offset:0
    ds_read_b64 v[42:43], v2 offset:20992
    v_perm_b32 v112, v98, v96, s52
    s_waitcnt lgkmcnt(13)
    v_perm_b32 v116, v99, v97, s53
    ds_read_b32 v108, v28 offset:0
    ds_read_b32 v109, v29 offset:0
    s_waitcnt lgkmcnt(11)
    ds_read_b64 v[44:45], v2 offset:21504
    ds_read_b32 v110, v30 offset:0
    ds_read_b32 v111, v31 offset:0
    ds_read_b64 v[46:47], v2 offset:22016
    s_waitcnt lgkmcnt(14)
    v_perm_b32 v113, v102, v100, s52
    s_waitcnt lgkmcnt(13)
    v_perm_b32 v117, v103, v101, s53
    s_barrier
    v_pk_fma_f32 v[32:33], v[32:33], s[50:51], v[48:49]
    v_pk_fma_f32 v[34:35], v[34:35], s[50:51], v[48:49]
    s_waitcnt lgkmcnt(8)
    v_perm_b32 v114, v106, v104, s52
    s_waitcnt lgkmcnt(7)
    v_perm_b32 v118, v107, v105, s53
    s_waitcnt lgkmcnt(2)
    v_perm_b32 v115, v110, v108, s52
    s_waitcnt lgkmcnt(1)
    v_perm_b32 v119, v111, v109, s53
    v_pk_fma_f32 v[36:37], v[36:37], s[50:51], v[48:49]
    ds_read_b32 v96, v32 offset:0
    ds_read_b32 v97, v33 offset:0
    ds_read_b64 v[16:17], v2 offset:36864
    v_pk_fma_f32 v[38:39], v[38:39], s[50:51], v[48:49]
    ds_read_b32 v98, v34 offset:0
    ds_read_b32 v99, v35 offset:0
    ds_read_b64 v[18:19], v2 offset:37376
    v_pk_fma_f32 v[40:41], v[40:41], s[50:51], v[48:49]
    ds_read_b32 v100, v36 offset:0
    ds_read_b32 v101, v37 offset:0
    ds_read_b64 v[20:21], v2 offset:37888
    v_pk_fma_f32 v[42:43], v[42:43], s[50:51], v[48:49]
    ds_read_b32 v102, v38 offset:0
    ds_read_b32 v103, v39 offset:0
    ds_read_b64 v[22:23], v2 offset:38400
    v_pk_fma_f32 v[44:45], v[44:45], s[50:51], v[48:49]
    ds_read_b32 v104, v40 offset:0
    ds_read_b32 v105, v41 offset:0
    s_waitcnt lgkmcnt(11)
    ds_read_b64 v[24:25], v2 offset:38912
    v_pk_fma_f32 v[46:47], v[46:47], s[50:51], v[48:49]
    ds_read_b32 v106, v42 offset:0
    ds_read_b32 v107, v43 offset:0
    ds_read_b64 v[26:27], v2 offset:39424
    s_waitcnt lgkmcnt(14)
    v_perm_b32 v120, v98, v96, s52
    s_waitcnt lgkmcnt(13)
    v_perm_b32 v124, v99, v97, s53
    ds_read_b32 v108, v44 offset:0
    ds_read_b32 v109, v45 offset:0
    s_waitcnt lgkmcnt(11)
    ds_read_b64 v[28:29], v2 offset:39936
    ds_read_b32 v110, v46 offset:0
    ds_read_b32 v111, v47 offset:0
    ds_read_b64 v[30:31], v2 offset:40448
    s_waitcnt lgkmcnt(14)
    v_perm_b32 v121, v102, v100, s52
    s_waitcnt lgkmcnt(13)
    v_perm_b32 v125, v103, v101, s53
    s_barrier
    v_pk_fma_f32 v[16:17], v[16:17], s[50:51], v[48:49]
    v_pk_fma_f32 v[18:19], v[18:19], s[50:51], v[48:49]
    s_waitcnt lgkmcnt(8)
    v_perm_b32 v122, v106, v104, s52
    s_waitcnt lgkmcnt(7)
    v_perm_b32 v126, v107, v105, s53
    s_waitcnt lgkmcnt(2)
    v_perm_b32 v123, v110, v108, s52
    s_waitcnt lgkmcnt(1)
    v_perm_b32 v127, v111, v109, s53
    v_pk_fma_f32 v[20:21], v[20:21], s[50:51], v[48:49]
    ds_read_b32 v96, v16 offset:0
    ds_read_b32 v97, v17 offset:0
    ds_read_b64 v[32:33], v3 offset:0
    v_pk_fma_f32 v[22:23], v[22:23], s[50:51], v[48:49]
    ds_read_b32 v98, v18 offset:0
    ds_read_b32 v99, v19 offset:0
    ds_read_b64 v[34:35], v3 offset:512
    v_pk_fma_f32 v[24:25], v[24:25], s[50:51], v[48:49]
    ds_read_b32 v100, v20 offset:0
    ds_read_b32 v101, v21 offset:0
    ds_read_b64 v[36:37], v3 offset:1024
    v_pk_fma_f32 v[26:27], v[26:27], s[50:51], v[48:49]
    ds_read_b32 v102, v22 offset:0
    ds_read_b32 v103, v23 offset:0
    ds_read_b64 v[38:39], v3 offset:1536
    v_pk_fma_f32 v[28:29], v[28:29], s[50:51], v[48:49]
    ds_read_b32 v104, v24 offset:0
    ds_read_b32 v105, v25 offset:0
    s_waitcnt lgkmcnt(11)
    ds_read_b64 v[40:41], v3 offset:2048
    v_pk_fma_f32 v[30:31], v[30:31], s[50:51], v[48:49]
    ds_read_b32 v106, v26 offset:0
    ds_read_b32 v107, v27 offset:0
    ds_read_b64 v[42:43], v3 offset:2560
    s_waitcnt lgkmcnt(14)
    v_perm_b32 v128, v98, v96, s52
    s_waitcnt lgkmcnt(13)
    v_perm_b32 v132, v99, v97, s53
    ds_read_b32 v108, v28 offset:0
    ds_read_b32 v109, v29 offset:0
    s_waitcnt lgkmcnt(11)
    ds_read_b64 v[44:45], v3 offset:3072
    ds_read_b32 v110, v30 offset:0
    ds_read_b32 v111, v31 offset:0
    ds_read_b64 v[46:47], v3 offset:3584
    s_waitcnt lgkmcnt(14)
    v_perm_b32 v129, v102, v100, s52
    s_waitcnt lgkmcnt(13)
    v_perm_b32 v133, v103, v101, s53
    s_barrier
    v_pk_fma_f32 v[32:33], v[32:33], s[50:51], v[48:49]
    v_pk_fma_f32 v[34:35], v[34:35], s[50:51], v[48:49]
    s_waitcnt lgkmcnt(8)
    v_perm_b32 v130, v106, v104, s52
    s_waitcnt lgkmcnt(7)
    v_perm_b32 v134, v107, v105, s53
    s_waitcnt lgkmcnt(2)
    v_perm_b32 v131, v110, v108, s52
    s_waitcnt lgkmcnt(1)
    v_perm_b32 v135, v111, v109, s53
    v_pk_fma_f32 v[36:37], v[36:37], s[50:51], v[48:49]
    ds_read_b32 v96, v32 offset:0
    ds_read_b32 v97, v33 offset:0
    ds_read_b64 v[16:17], v3 offset:18432
    v_pk_fma_f32 v[38:39], v[38:39], s[50:51], v[48:49]
    ds_read_b32 v98, v34 offset:0
    ds_read_b32 v99, v35 offset:0
    ds_read_b64 v[18:19], v3 offset:18944
    v_pk_fma_f32 v[40:41], v[40:41], s[50:51], v[48:49]
    ds_read_b32 v100, v36 offset:0
    ds_read_b32 v101, v37 offset:0
    ds_read_b64 v[20:21], v3 offset:19456
    v_pk_fma_f32 v[42:43], v[42:43], s[50:51], v[48:49]
    ds_read_b32 v102, v38 offset:0
    ds_read_b32 v103, v39 offset:0
    ds_read_b64 v[22:23], v3 offset:19968
    v_pk_fma_f32 v[44:45], v[44:45], s[50:51], v[48:49]
    ds_read_b32 v104, v40 offset:0
    ds_read_b32 v105, v41 offset:0
    s_waitcnt lgkmcnt(11)
    ds_read_b64 v[24:25], v3 offset:20480
    v_pk_fma_f32 v[46:47], v[46:47], s[50:51], v[48:49]
    ds_read_b32 v106, v42 offset:0
    ds_read_b32 v107, v43 offset:0
    ds_read_b64 v[26:27], v3 offset:20992
    s_waitcnt lgkmcnt(14)
    v_perm_b32 v136, v98, v96, s52
    s_waitcnt lgkmcnt(13)
    v_perm_b32 v140, v99, v97, s53
    ds_read_b32 v108, v44 offset:0
    ds_read_b32 v109, v45 offset:0
    s_waitcnt lgkmcnt(11)
    ds_read_b64 v[28:29], v3 offset:21504
    ds_read_b32 v110, v46 offset:0
    ds_read_b32 v111, v47 offset:0
    ds_read_b64 v[30:31], v3 offset:22016
    s_waitcnt lgkmcnt(14)
    v_perm_b32 v137, v102, v100, s52
    s_waitcnt lgkmcnt(13)
    v_perm_b32 v141, v103, v101, s53
    s_barrier
    v_pk_fma_f32 v[16:17], v[16:17], s[50:51], v[48:49]
    v_pk_fma_f32 v[18:19], v[18:19], s[50:51], v[48:49]
    s_waitcnt lgkmcnt(8)
    v_perm_b32 v138, v106, v104, s52
    s_waitcnt lgkmcnt(7)
    v_perm_b32 v142, v107, v105, s53
    s_waitcnt lgkmcnt(2)
    v_perm_b32 v139, v110, v108, s52
    s_waitcnt lgkmcnt(1)
    v_perm_b32 v143, v111, v109, s53
    v_pk_fma_f32 v[20:21], v[20:21], s[50:51], v[48:49]
    ds_read_b32 v96, v16 offset:0
    ds_read_b32 v97, v17 offset:0
    ds_read_b64 v[32:33], v3 offset:36864
    v_pk_fma_f32 v[22:23], v[22:23], s[50:51], v[48:49]
    ds_read_b32 v98, v18 offset:0
    ds_read_b32 v99, v19 offset:0
    ds_read_b64 v[34:35], v3 offset:37376
    v_pk_fma_f32 v[24:25], v[24:25], s[50:51], v[48:49]
    ds_read_b32 v100, v20 offset:0
    ds_read_b32 v101, v21 offset:0
    ds_read_b64 v[36:37], v3 offset:37888
    v_pk_fma_f32 v[26:27], v[26:27], s[50:51], v[48:49]
    ds_read_b32 v102, v22 offset:0
    ds_read_b32 v103, v23 offset:0
    ds_read_b64 v[38:39], v3 offset:38400
    v_pk_fma_f32 v[28:29], v[28:29], s[50:51], v[48:49]
    ds_read_b32 v104, v24 offset:0
    ds_read_b32 v105, v25 offset:0
    s_waitcnt lgkmcnt(11)
    ds_read_b64 v[40:41], v3 offset:38912
    v_pk_fma_f32 v[30:31], v[30:31], s[50:51], v[48:49]
    ds_read_b32 v106, v26 offset:0
    ds_read_b32 v107, v27 offset:0
    ds_read_b64 v[42:43], v3 offset:39424
    s_waitcnt lgkmcnt(14)
    v_perm_b32 v144, v98, v96, s52
    s_waitcnt lgkmcnt(13)
    v_perm_b32 v148, v99, v97, s53
    ds_read_b32 v108, v28 offset:0
    ds_read_b32 v109, v29 offset:0
    s_waitcnt lgkmcnt(11)
    ds_read_b64 v[44:45], v3 offset:39936
    ds_read_b32 v110, v30 offset:0
    ds_read_b32 v111, v31 offset:0
    ds_read_b64 v[46:47], v3 offset:40448
    s_waitcnt lgkmcnt(14)
    v_perm_b32 v145, v102, v100, s52
    s_waitcnt lgkmcnt(13)
    v_perm_b32 v149, v103, v101, s53
    s_barrier
    v_pk_fma_f32 v[32:33], v[32:33], s[50:51], v[48:49]
    v_pk_fma_f32 v[34:35], v[34:35], s[50:51], v[48:49]
    s_waitcnt lgkmcnt(8)
    v_perm_b32 v146, v106, v104, s52
    s_waitcnt lgkmcnt(7)
    v_perm_b32 v150, v107, v105, s53
    s_waitcnt lgkmcnt(2)
    v_perm_b32 v147, v110, v108, s52
    s_waitcnt lgkmcnt(1)
    v_perm_b32 v151, v111, v109, s53
    v_pk_fma_f32 v[36:37], v[36:37], s[50:51], v[48:49]
    ds_read_b32 v96, v32 offset:0
    ds_read_b32 v97, v33 offset:0
    ds_read_b64 v[16:17], v4 offset:0
    v_pk_fma_f32 v[38:39], v[38:39], s[50:51], v[48:49]
    ds_read_b32 v98, v34 offset:0
    ds_read_b32 v99, v35 offset:0
    ds_read_b64 v[18:19], v4 offset:512
    v_pk_fma_f32 v[40:41], v[40:41], s[50:51], v[48:49]
    ds_read_b32 v100, v36 offset:0
    ds_read_b32 v101, v37 offset:0
    ds_read_b64 v[20:21], v4 offset:1024
    v_pk_fma_f32 v[42:43], v[42:43], s[50:51], v[48:49]
    ds_read_b32 v102, v38 offset:0
    ds_read_b32 v103, v39 offset:0
    ds_read_b64 v[22:23], v4 offset:1536
    v_pk_fma_f32 v[44:45], v[44:45], s[50:51], v[48:49]
    ds_read_b32 v104, v40 offset:0
    ds_read_b32 v105, v41 offset:0
    s_waitcnt lgkmcnt(11)
    ds_read_b64 v[24:25], v4 offset:2048
    v_pk_fma_f32 v[46:47], v[46:47], s[50:51], v[48:49]
    ds_read_b32 v106, v42 offset:0
    ds_read_b32 v107, v43 offset:0
    ds_read_b64 v[26:27], v4 offset:2560
    s_waitcnt lgkmcnt(14)
    v_perm_b32 v152, v98, v96, s52
    s_waitcnt lgkmcnt(13)
    v_perm_b32 v156, v99, v97, s53
    ds_read_b32 v108, v44 offset:0
    ds_read_b32 v109, v45 offset:0
    s_waitcnt lgkmcnt(11)
    ds_read_b64 v[28:29], v4 offset:3072
    ds_read_b32 v110, v46 offset:0
    ds_read_b32 v111, v47 offset:0
    ds_read_b64 v[30:31], v4 offset:3584
    s_waitcnt lgkmcnt(14)
    v_perm_b32 v153, v102, v100, s52
    s_waitcnt lgkmcnt(13)
    v_perm_b32 v157, v103, v101, s53
    s_barrier
    v_pk_fma_f32 v[16:17], v[16:17], s[50:51], v[48:49]
    v_pk_fma_f32 v[18:19], v[18:19], s[50:51], v[48:49]
    s_waitcnt lgkmcnt(8)
    v_perm_b32 v154, v106, v104, s52
    s_waitcnt lgkmcnt(7)
    v_perm_b32 v158, v107, v105, s53
    s_waitcnt lgkmcnt(2)
    v_perm_b32 v155, v110, v108, s52
    s_waitcnt lgkmcnt(1)
    v_perm_b32 v159, v111, v109, s53
    v_pk_fma_f32 v[20:21], v[20:21], s[50:51], v[48:49]
    ds_read_b32 v96, v16 offset:0
    ds_read_b32 v97, v17 offset:0
    ds_read_b64 v[32:33], v4 offset:18432
    v_pk_fma_f32 v[22:23], v[22:23], s[50:51], v[48:49]
    ds_read_b32 v98, v18 offset:0
    ds_read_b32 v99, v19 offset:0
    ds_read_b64 v[34:35], v4 offset:18944
    v_pk_fma_f32 v[24:25], v[24:25], s[50:51], v[48:49]
    ds_read_b32 v100, v20 offset:0
    ds_read_b32 v101, v21 offset:0
    ds_read_b64 v[36:37], v4 offset:19456
    v_pk_fma_f32 v[26:27], v[26:27], s[50:51], v[48:49]
    ds_read_b32 v102, v22 offset:0
    ds_read_b32 v103, v23 offset:0
    ds_read_b64 v[38:39], v4 offset:19968
    v_pk_fma_f32 v[28:29], v[28:29], s[50:51], v[48:49]
    ds_read_b32 v104, v24 offset:0
    ds_read_b32 v105, v25 offset:0
    s_waitcnt lgkmcnt(11)
    ds_read_b64 v[40:41], v4 offset:20480
    v_pk_fma_f32 v[30:31], v[30:31], s[50:51], v[48:49]
    ds_read_b32 v106, v26 offset:0
    ds_read_b32 v107, v27 offset:0
    ds_read_b64 v[42:43], v4 offset:20992
    s_waitcnt lgkmcnt(14)
    v_perm_b32 v160, v98, v96, s52
    s_waitcnt lgkmcnt(13)
    v_perm_b32 v164, v99, v97, s53
    ds_read_b32 v108, v28 offset:0
    ds_read_b32 v109, v29 offset:0
    s_waitcnt lgkmcnt(11)
    ds_read_b64 v[44:45], v4 offset:21504
    ds_read_b32 v110, v30 offset:0
    ds_read_b32 v111, v31 offset:0
    ds_read_b64 v[46:47], v4 offset:22016
    s_waitcnt lgkmcnt(14)
    v_perm_b32 v161, v102, v100, s52
    s_waitcnt lgkmcnt(13)
    v_perm_b32 v165, v103, v101, s53
    s_barrier
    v_pk_fma_f32 v[32:33], v[32:33], s[50:51], v[48:49]
    v_pk_fma_f32 v[34:35], v[34:35], s[50:51], v[48:49]
    s_waitcnt lgkmcnt(8)
    v_perm_b32 v162, v106, v104, s52
    s_waitcnt lgkmcnt(7)
    v_perm_b32 v166, v107, v105, s53
    s_waitcnt lgkmcnt(2)
    v_perm_b32 v163, v110, v108, s52
    s_waitcnt lgkmcnt(1)
    v_perm_b32 v167, v111, v109, s53
    v_pk_fma_f32 v[36:37], v[36:37], s[50:51], v[48:49]
    ds_read_b32 v96, v32 offset:0
    ds_read_b32 v97, v33 offset:0
    ds_read_b64 v[16:17], v2 offset:0
    v_pk_fma_f32 v[38:39], v[38:39], s[50:51], v[48:49]
    ds_read_b32 v98, v34 offset:0
    ds_read_b32 v99, v35 offset:0
    ds_read_b64 v[18:19], v2 offset:512
    v_pk_fma_f32 v[40:41], v[40:41], s[50:51], v[48:49]
    ds_read_b32 v100, v36 offset:0
    ds_read_b32 v101, v37 offset:0
    ds_read_b64 v[20:21], v2 offset:1024
    v_pk_fma_f32 v[42:43], v[42:43], s[50:51], v[48:49]
    ds_read_b32 v102, v38 offset:0
    ds_read_b32 v103, v39 offset:0
    ds_read_b64 v[22:23], v2 offset:1536
    v_pk_fma_f32 v[44:45], v[44:45], s[50:51], v[48:49]
    ds_read_b32 v104, v40 offset:0
    ds_read_b32 v105, v41 offset:0
    s_waitcnt lgkmcnt(11)
    ds_read_b64 v[24:25], v2 offset:2048
    v_pk_fma_f32 v[46:47], v[46:47], s[50:51], v[48:49]
    ds_read_b32 v106, v42 offset:0
    ds_read_b32 v107, v43 offset:0
    ds_read_b64 v[26:27], v2 offset:2560
    s_waitcnt lgkmcnt(14)
    v_perm_b32 v168, v98, v96, s52
    s_waitcnt lgkmcnt(13)
    v_perm_b32 v172, v99, v97, s53
    ds_read_b32 v108, v44 offset:0
    ds_read_b32 v109, v45 offset:0
    s_waitcnt lgkmcnt(11)
    ds_read_b64 v[28:29], v2 offset:3072
    ds_read_b32 v110, v46 offset:0
    ds_read_b32 v111, v47 offset:0
    ds_read_b64 v[30:31], v2 offset:3584
    s_waitcnt lgkmcnt(14)
    v_perm_b32 v169, v102, v100, s52
    s_waitcnt lgkmcnt(13)
    v_perm_b32 v173, v103, v101, s53
    s_barrier
    v_pk_fma_f32 v[16:17], v[16:17], s[50:51], v[48:49]
    v_pk_fma_f32 v[18:19], v[18:19], s[50:51], v[48:49]
    s_waitcnt lgkmcnt(8)
    v_perm_b32 v170, v106, v104, s52
    s_waitcnt lgkmcnt(7)
    v_perm_b32 v174, v107, v105, s53
    s_waitcnt lgkmcnt(2)
    v_perm_b32 v171, v110, v108, s52
    s_waitcnt lgkmcnt(1)
    v_perm_b32 v175, v111, v109, s53
    v_pk_fma_f32 v[20:21], v[20:21], s[50:51], v[48:49]
    ds_read_b32 v96, v16 offset:0
    ds_read_b32 v97, v17 offset:0
    ds_read_b64 v[32:33], v2 offset:18432
    v_pk_fma_f32 v[22:23], v[22:23], s[50:51], v[48:49]
    ds_read_b32 v98, v18 offset:0
    ds_read_b32 v99, v19 offset:0
    ds_read_b64 v[34:35], v2 offset:18944
    v_pk_fma_f32 v[24:25], v[24:25], s[50:51], v[48:49]
    ds_read_b32 v100, v20 offset:0
    ds_read_b32 v101, v21 offset:0
    ds_read_b64 v[36:37], v2 offset:19456
    v_pk_fma_f32 v[26:27], v[26:27], s[50:51], v[48:49]
    ds_read_b32 v102, v22 offset:0
    ds_read_b32 v103, v23 offset:0
    ds_read_b64 v[38:39], v2 offset:19968
    v_pk_fma_f32 v[28:29], v[28:29], s[50:51], v[48:49]
    ds_read_b32 v104, v24 offset:0
    ds_read_b32 v105, v25 offset:0
    s_waitcnt lgkmcnt(11)
    ds_read_b64 v[40:41], v2 offset:20480
    v_pk_fma_f32 v[30:31], v[30:31], s[50:51], v[48:49]
    ds_read_b32 v106, v26 offset:0
    ds_read_b32 v107, v27 offset:0
    ds_read_b64 v[42:43], v2 offset:20992
    s_waitcnt lgkmcnt(14)
    v_perm_b32 v176, v98, v96, s52
    s_waitcnt lgkmcnt(13)
    v_perm_b32 v180, v99, v97, s53
    ds_read_b32 v108, v28 offset:0
    ds_read_b32 v109, v29 offset:0
    s_waitcnt lgkmcnt(11)
    ds_read_b64 v[44:45], v2 offset:21504
    ds_read_b32 v110, v30 offset:0
    ds_read_b32 v111, v31 offset:0
    ds_read_b64 v[46:47], v2 offset:22016
    s_waitcnt lgkmcnt(14)
    v_perm_b32 v177, v102, v100, s52
    s_waitcnt lgkmcnt(13)
    v_perm_b32 v181, v103, v101, s53
    s_barrier
    v_pk_fma_f32 v[32:33], v[32:33], s[50:51], v[48:49]
    v_pk_fma_f32 v[34:35], v[34:35], s[50:51], v[48:49]
    s_waitcnt lgkmcnt(8)
    v_perm_b32 v178, v106, v104, s52
    s_waitcnt lgkmcnt(7)
    v_perm_b32 v182, v107, v105, s53
    s_waitcnt lgkmcnt(2)
    v_perm_b32 v179, v110, v108, s52
    s_waitcnt lgkmcnt(1)
    v_perm_b32 v183, v111, v109, s53
    v_pk_fma_f32 v[36:37], v[36:37], s[50:51], v[48:49]
    ds_read_b32 v96, v32 offset:0
    ds_read_b32 v97, v33 offset:0
    ds_read_b64 v[16:17], v2 offset:36864
    v_pk_fma_f32 v[38:39], v[38:39], s[50:51], v[48:49]
    ds_read_b32 v98, v34 offset:0
    ds_read_b32 v99, v35 offset:0
    ds_read_b64 v[18:19], v2 offset:37376
    v_pk_fma_f32 v[40:41], v[40:41], s[50:51], v[48:49]
    ds_read_b32 v100, v36 offset:0
    ds_read_b32 v101, v37 offset:0
    ds_read_b64 v[20:21], v2 offset:37888
    v_pk_fma_f32 v[42:43], v[42:43], s[50:51], v[48:49]
    ds_read_b32 v102, v38 offset:0
    ds_read_b32 v103, v39 offset:0
    ds_read_b64 v[22:23], v2 offset:38400
    v_pk_fma_f32 v[44:45], v[44:45], s[50:51], v[48:49]
    ds_read_b32 v104, v40 offset:0
    ds_read_b32 v105, v41 offset:0
    s_waitcnt lgkmcnt(11)
    ds_read_b64 v[24:25], v2 offset:38912
    v_pk_fma_f32 v[46:47], v[46:47], s[50:51], v[48:49]
    ds_read_b32 v106, v42 offset:0
    ds_read_b32 v107, v43 offset:0
    ds_read_b64 v[26:27], v2 offset:39424
    s_waitcnt lgkmcnt(14)
    v_perm_b32 v184, v98, v96, s52
    s_waitcnt lgkmcnt(13)
    v_perm_b32 v188, v99, v97, s53
    ds_read_b32 v108, v44 offset:0
    ds_read_b32 v109, v45 offset:0
    s_waitcnt lgkmcnt(11)
    ds_read_b64 v[28:29], v2 offset:39936
    ds_read_b32 v110, v46 offset:0
    ds_read_b32 v111, v47 offset:0
    ds_read_b64 v[30:31], v2 offset:40448
    s_waitcnt lgkmcnt(14)
    v_perm_b32 v185, v102, v100, s52
    s_waitcnt lgkmcnt(13)
    v_perm_b32 v189, v103, v101, s53
    s_barrier
    v_pk_fma_f32 v[16:17], v[16:17], s[50:51], v[48:49]
    v_pk_fma_f32 v[18:19], v[18:19], s[50:51], v[48:49]
    s_waitcnt lgkmcnt(8)
    v_perm_b32 v186, v106, v104, s52
    s_waitcnt lgkmcnt(7)
    v_perm_b32 v190, v107, v105, s53
    s_waitcnt lgkmcnt(2)
    v_perm_b32 v187, v110, v108, s52
    s_waitcnt lgkmcnt(1)
    v_perm_b32 v191, v111, v109, s53
    v_pk_fma_f32 v[20:21], v[20:21], s[50:51], v[48:49]
    ds_read_b32 v96, v16 offset:0
    ds_read_b32 v97, v17 offset:0
    ds_read_b64 v[32:33], v3 offset:0
    v_pk_fma_f32 v[22:23], v[22:23], s[50:51], v[48:49]
    ds_read_b32 v98, v18 offset:0
    ds_read_b32 v99, v19 offset:0
    ds_read_b64 v[34:35], v3 offset:512
    v_pk_fma_f32 v[24:25], v[24:25], s[50:51], v[48:49]
    ds_read_b32 v100, v20 offset:0
    ds_read_b32 v101, v21 offset:0
    ds_read_b64 v[36:37], v3 offset:1024
    v_pk_fma_f32 v[26:27], v[26:27], s[50:51], v[48:49]
    ds_read_b32 v102, v22 offset:0
    ds_read_b32 v103, v23 offset:0
    ds_read_b64 v[38:39], v3 offset:1536
    v_pk_fma_f32 v[28:29], v[28:29], s[50:51], v[48:49]
    ds_read_b32 v104, v24 offset:0
    ds_read_b32 v105, v25 offset:0
    s_waitcnt lgkmcnt(11)
    ds_read_b64 v[40:41], v3 offset:2048
    v_pk_fma_f32 v[30:31], v[30:31], s[50:51], v[48:49]
    ds_read_b32 v106, v26 offset:0
    ds_read_b32 v107, v27 offset:0
    ds_read_b64 v[42:43], v3 offset:2560
    s_waitcnt lgkmcnt(14)
    v_perm_b32 v192, v98, v96, s52
    s_waitcnt lgkmcnt(13)
    v_perm_b32 v196, v99, v97, s53
    ds_read_b32 v108, v28 offset:0
    ds_read_b32 v109, v29 offset:0
    s_waitcnt lgkmcnt(11)
    ds_read_b64 v[44:45], v3 offset:3072
    ds_read_b32 v110, v30 offset:0
    ds_read_b32 v111, v31 offset:0
    ds_read_b64 v[46:47], v3 offset:3584
    s_waitcnt lgkmcnt(14)
    v_perm_b32 v193, v102, v100, s52
    s_waitcnt lgkmcnt(13)
    v_perm_b32 v197, v103, v101, s53
    s_barrier
    v_pk_fma_f32 v[32:33], v[32:33], s[50:51], v[48:49]
    v_pk_fma_f32 v[34:35], v[34:35], s[50:51], v[48:49]
    s_waitcnt lgkmcnt(8)
    v_perm_b32 v194, v106, v104, s52
    s_waitcnt lgkmcnt(7)
    v_perm_b32 v198, v107, v105, s53
    s_waitcnt lgkmcnt(2)
    v_perm_b32 v195, v110, v108, s52
    s_waitcnt lgkmcnt(1)
    v_perm_b32 v199, v111, v109, s53
    v_pk_fma_f32 v[36:37], v[36:37], s[50:51], v[48:49]
    ds_read_b32 v96, v32 offset:0
    ds_read_b32 v97, v33 offset:0
    ds_read_b64 v[16:17], v3 offset:18432
    v_pk_fma_f32 v[38:39], v[38:39], s[50:51], v[48:49]
    ds_read_b32 v98, v34 offset:0
    ds_read_b32 v99, v35 offset:0
    ds_read_b64 v[18:19], v3 offset:18944
    v_pk_fma_f32 v[40:41], v[40:41], s[50:51], v[48:49]
    ds_read_b32 v100, v36 offset:0
    ds_read_b32 v101, v37 offset:0
    ds_read_b64 v[20:21], v3 offset:19456
    v_pk_fma_f32 v[42:43], v[42:43], s[50:51], v[48:49]
    ds_read_b32 v102, v38 offset:0
    ds_read_b32 v103, v39 offset:0
    ds_read_b64 v[22:23], v3 offset:19968
    v_pk_fma_f32 v[44:45], v[44:45], s[50:51], v[48:49]
    ds_read_b32 v104, v40 offset:0
    ds_read_b32 v105, v41 offset:0
    s_waitcnt lgkmcnt(11)
    ds_read_b64 v[24:25], v3 offset:20480
    v_pk_fma_f32 v[46:47], v[46:47], s[50:51], v[48:49]
    ds_read_b32 v106, v42 offset:0
    ds_read_b32 v107, v43 offset:0
    ds_read_b64 v[26:27], v3 offset:20992
    s_waitcnt lgkmcnt(14)
    v_perm_b32 v200, v98, v96, s52
    s_waitcnt lgkmcnt(13)
    v_perm_b32 v204, v99, v97, s53
    ds_read_b32 v108, v44 offset:0
    ds_read_b32 v109, v45 offset:0
    s_waitcnt lgkmcnt(11)
    ds_read_b64 v[28:29], v3 offset:21504
    ds_read_b32 v110, v46 offset:0
    ds_read_b32 v111, v47 offset:0
    ds_read_b64 v[30:31], v3 offset:22016
    s_waitcnt lgkmcnt(14)
    v_perm_b32 v201, v102, v100, s52
    s_waitcnt lgkmcnt(13)
    v_perm_b32 v205, v103, v101, s53
    s_barrier
    v_pk_fma_f32 v[16:17], v[16:17], s[50:51], v[48:49]
    v_pk_fma_f32 v[18:19], v[18:19], s[50:51], v[48:49]
    s_waitcnt lgkmcnt(8)
    v_perm_b32 v202, v106, v104, s52
    s_waitcnt lgkmcnt(7)
    v_perm_b32 v206, v107, v105, s53
    s_waitcnt lgkmcnt(2)
    v_perm_b32 v203, v110, v108, s52
    s_waitcnt lgkmcnt(1)
    v_perm_b32 v207, v111, v109, s53
    v_pk_fma_f32 v[20:21], v[20:21], s[50:51], v[48:49]
    ds_read_b32 v96, v16 offset:0
    ds_read_b32 v97, v17 offset:0
    ds_read_b64 v[32:33], v3 offset:36864
    v_pk_fma_f32 v[22:23], v[22:23], s[50:51], v[48:49]
    ds_read_b32 v98, v18 offset:0
    ds_read_b32 v99, v19 offset:0
    ds_read_b64 v[34:35], v3 offset:37376
    v_pk_fma_f32 v[24:25], v[24:25], s[50:51], v[48:49]
    ds_read_b32 v100, v20 offset:0
    ds_read_b32 v101, v21 offset:0
    ds_read_b64 v[36:37], v3 offset:37888
    v_pk_fma_f32 v[26:27], v[26:27], s[50:51], v[48:49]
    ds_read_b32 v102, v22 offset:0
    ds_read_b32 v103, v23 offset:0
    ds_read_b64 v[38:39], v3 offset:38400
    v_pk_fma_f32 v[28:29], v[28:29], s[50:51], v[48:49]
    ds_read_b32 v104, v24 offset:0
    ds_read_b32 v105, v25 offset:0
    s_waitcnt lgkmcnt(11)
    ds_read_b64 v[40:41], v3 offset:38912
    v_pk_fma_f32 v[30:31], v[30:31], s[50:51], v[48:49]
    ds_read_b32 v106, v26 offset:0
    ds_read_b32 v107, v27 offset:0
    ds_read_b64 v[42:43], v3 offset:39424
    s_waitcnt lgkmcnt(14)
    v_perm_b32 v208, v98, v96, s52
    s_waitcnt lgkmcnt(13)
    v_perm_b32 v212, v99, v97, s53
    ds_read_b32 v108, v28 offset:0
    ds_read_b32 v109, v29 offset:0
    s_waitcnt lgkmcnt(11)
    ds_read_b64 v[44:45], v3 offset:39936
    ds_read_b32 v110, v30 offset:0
    ds_read_b32 v111, v31 offset:0
    ds_read_b64 v[46:47], v3 offset:40448
    s_waitcnt lgkmcnt(14)
    v_perm_b32 v209, v102, v100, s52
    s_waitcnt lgkmcnt(13)
    v_perm_b32 v213, v103, v101, s53
    s_barrier
    v_pk_fma_f32 v[32:33], v[32:33], s[50:51], v[48:49]
    v_pk_fma_f32 v[34:35], v[34:35], s[50:51], v[48:49]
    s_waitcnt lgkmcnt(8)
    v_perm_b32 v210, v106, v104, s52
    s_waitcnt lgkmcnt(7)
    v_perm_b32 v214, v107, v105, s53
    s_waitcnt lgkmcnt(2)
    v_perm_b32 v211, v110, v108, s52
    s_waitcnt lgkmcnt(1)
    v_perm_b32 v215, v111, v109, s53
    v_pk_fma_f32 v[36:37], v[36:37], s[50:51], v[48:49]
    ds_read_b32 v96, v32 offset:0
    ds_read_b32 v97, v33 offset:0
    ds_read_b64 v[16:17], v4 offset:0
    v_pk_fma_f32 v[38:39], v[38:39], s[50:51], v[48:49]
    ds_read_b32 v98, v34 offset:0
    ds_read_b32 v99, v35 offset:0
    ds_read_b64 v[18:19], v4 offset:512
    v_pk_fma_f32 v[40:41], v[40:41], s[50:51], v[48:49]
    ds_read_b32 v100, v36 offset:0
    ds_read_b32 v101, v37 offset:0
    ds_read_b64 v[20:21], v4 offset:1024
    v_pk_fma_f32 v[42:43], v[42:43], s[50:51], v[48:49]
    ds_read_b32 v102, v38 offset:0
    ds_read_b32 v103, v39 offset:0
    ds_read_b64 v[22:23], v4 offset:1536
    v_pk_fma_f32 v[44:45], v[44:45], s[50:51], v[48:49]
    ds_read_b32 v104, v40 offset:0
    ds_read_b32 v105, v41 offset:0
    s_waitcnt lgkmcnt(11)
    ds_read_b64 v[24:25], v4 offset:2048
    v_pk_fma_f32 v[46:47], v[46:47], s[50:51], v[48:49]
    ds_read_b32 v106, v42 offset:0
    ds_read_b32 v107, v43 offset:0
    ds_read_b64 v[26:27], v4 offset:2560
    s_waitcnt lgkmcnt(14)
    v_perm_b32 v216, v98, v96, s52
    s_waitcnt lgkmcnt(13)
    v_perm_b32 v220, v99, v97, s53
    ds_read_b32 v108, v44 offset:0
    ds_read_b32 v109, v45 offset:0
    s_waitcnt lgkmcnt(11)
    ds_read_b64 v[28:29], v4 offset:3072
    ds_read_b32 v110, v46 offset:0
    ds_read_b32 v111, v47 offset:0
    ds_read_b64 v[30:31], v4 offset:3584
    s_waitcnt lgkmcnt(14)
    v_perm_b32 v217, v102, v100, s52
    s_waitcnt lgkmcnt(13)
    v_perm_b32 v221, v103, v101, s53
    s_barrier
    v_pk_fma_f32 v[16:17], v[16:17], s[50:51], v[48:49]
    v_pk_fma_f32 v[18:19], v[18:19], s[50:51], v[48:49]
    s_waitcnt lgkmcnt(8)
    v_perm_b32 v218, v106, v104, s52
    s_waitcnt lgkmcnt(7)
    v_perm_b32 v222, v107, v105, s53
    s_waitcnt lgkmcnt(2)
    v_perm_b32 v219, v110, v108, s52
    s_waitcnt lgkmcnt(1)
    v_perm_b32 v223, v111, v109, s53
    v_pk_fma_f32 v[20:21], v[20:21], s[50:51], v[48:49]
    ds_read_b32 v96, v16 offset:0
    ds_read_b32 v97, v17 offset:0
    ds_read_b64 v[32:33], v4 offset:18432
    v_pk_fma_f32 v[22:23], v[22:23], s[50:51], v[48:49]
    ds_read_b32 v98, v18 offset:0
    ds_read_b32 v99, v19 offset:0
    ds_read_b64 v[34:35], v4 offset:18944
    v_pk_fma_f32 v[24:25], v[24:25], s[50:51], v[48:49]
    ds_read_b32 v100, v20 offset:0
    ds_read_b32 v101, v21 offset:0
    ds_read_b64 v[36:37], v4 offset:19456
    v_pk_fma_f32 v[26:27], v[26:27], s[50:51], v[48:49]
    ds_read_b32 v102, v22 offset:0
    ds_read_b32 v103, v23 offset:0
    ds_read_b64 v[38:39], v4 offset:19968
    v_pk_fma_f32 v[28:29], v[28:29], s[50:51], v[48:49]
    ds_read_b32 v104, v24 offset:0
    ds_read_b32 v105, v25 offset:0
    s_waitcnt lgkmcnt(11)
    ds_read_b64 v[40:41], v4 offset:20480
    v_pk_fma_f32 v[30:31], v[30:31], s[50:51], v[48:49]
    ds_read_b32 v106, v26 offset:0
    ds_read_b32 v107, v27 offset:0
    ds_read_b64 v[42:43], v4 offset:20992
    s_waitcnt lgkmcnt(14)
    v_perm_b32 v224, v98, v96, s52
    s_waitcnt lgkmcnt(13)
    v_perm_b32 v228, v99, v97, s53
    ds_read_b32 v108, v28 offset:0
    ds_read_b32 v109, v29 offset:0
    s_waitcnt lgkmcnt(11)
    ds_read_b64 v[44:45], v4 offset:21504
    ds_read_b32 v110, v30 offset:0
    ds_read_b32 v111, v31 offset:0
    ds_read_b64 v[46:47], v4 offset:22016
    s_waitcnt lgkmcnt(14)
    v_perm_b32 v225, v102, v100, s52
    s_waitcnt lgkmcnt(13)
    v_perm_b32 v229, v103, v101, s53
    s_barrier
    v_pk_fma_f32 v[32:33], v[32:33], s[50:51], v[48:49]
    v_pk_fma_f32 v[34:35], v[34:35], s[50:51], v[48:49]
    s_waitcnt lgkmcnt(8)
    v_perm_b32 v226, v106, v104, s52
    s_waitcnt lgkmcnt(7)
    v_perm_b32 v230, v107, v105, s53
    s_waitcnt lgkmcnt(2)
    v_perm_b32 v227, v110, v108, s52
    s_waitcnt lgkmcnt(1)
    v_perm_b32 v231, v111, v109, s53
    v_pk_fma_f32 v[36:37], v[36:37], s[50:51], v[48:49]
    ds_read_b32 v96, v32 offset:0
    ds_read_b32 v97, v33 offset:0
    ds_read_b64 v[16:17], v2 offset:0
    v_pk_fma_f32 v[38:39], v[38:39], s[50:51], v[48:49]
    ds_read_b32 v98, v34 offset:0
    ds_read_b32 v99, v35 offset:0
    ds_read_b64 v[18:19], v2 offset:512
    v_pk_fma_f32 v[40:41], v[40:41], s[50:51], v[48:49]
    ds_read_b32 v100, v36 offset:0
    ds_read_b32 v101, v37 offset:0
    ds_read_b64 v[20:21], v2 offset:1024
    v_pk_fma_f32 v[42:43], v[42:43], s[50:51], v[48:49]
    ds_read_b32 v102, v38 offset:0
    ds_read_b32 v103, v39 offset:0
    ds_read_b64 v[22:23], v2 offset:1536
    v_pk_fma_f32 v[44:45], v[44:45], s[50:51], v[48:49]
    ds_read_b32 v104, v40 offset:0
    ds_read_b32 v105, v41 offset:0
    s_waitcnt lgkmcnt(11)
    ds_read_b64 v[24:25], v2 offset:2048
    v_pk_fma_f32 v[46:47], v[46:47], s[50:51], v[48:49]
    ds_read_b32 v106, v42 offset:0
    ds_read_b32 v107, v43 offset:0
    ds_read_b64 v[26:27], v2 offset:2560
    s_waitcnt lgkmcnt(14)
    v_perm_b32 v232, v98, v96, s52
    s_waitcnt lgkmcnt(13)
    v_perm_b32 v236, v99, v97, s53
    ds_read_b32 v108, v44 offset:0
    ds_read_b32 v109, v45 offset:0
    s_waitcnt lgkmcnt(11)
    ds_read_b64 v[28:29], v2 offset:3072
    ds_read_b32 v110, v46 offset:0
    ds_read_b32 v111, v47 offset:0
    ds_read_b64 v[30:31], v2 offset:3584
    s_waitcnt lgkmcnt(14)
    v_perm_b32 v233, v102, v100, s52
    s_waitcnt lgkmcnt(13)
    v_perm_b32 v237, v103, v101, s53
    s_barrier
    v_pk_fma_f32 v[16:17], v[16:17], s[50:51], v[48:49]
    v_pk_fma_f32 v[18:19], v[18:19], s[50:51], v[48:49]
    s_waitcnt lgkmcnt(8)
    v_perm_b32 v234, v106, v104, s52
    s_waitcnt lgkmcnt(7)
    v_perm_b32 v238, v107, v105, s53
    s_waitcnt lgkmcnt(2)
    v_perm_b32 v235, v110, v108, s52
    s_waitcnt lgkmcnt(1)
    v_perm_b32 v239, v111, v109, s53
    v_pk_fma_f32 v[20:21], v[20:21], s[50:51], v[48:49]
    ds_read_b32 v96, v16 offset:0
    ds_read_b32 v97, v17 offset:0
    ds_read_b64 v[32:33], v2 offset:18432
    v_pk_fma_f32 v[22:23], v[22:23], s[50:51], v[48:49]
    ds_read_b32 v98, v18 offset:0
    ds_read_b32 v99, v19 offset:0
    ds_read_b64 v[34:35], v2 offset:18944
    v_pk_fma_f32 v[24:25], v[24:25], s[50:51], v[48:49]
    ds_read_b32 v100, v20 offset:0
    ds_read_b32 v101, v21 offset:0
    ds_read_b64 v[36:37], v2 offset:19456
    v_pk_fma_f32 v[26:27], v[26:27], s[50:51], v[48:49]
    ds_read_b32 v102, v22 offset:0
    ds_read_b32 v103, v23 offset:0
    ds_read_b64 v[38:39], v2 offset:19968
    v_pk_fma_f32 v[28:29], v[28:29], s[50:51], v[48:49]
    ds_read_b32 v104, v24 offset:0
    ds_read_b32 v105, v25 offset:0
    s_waitcnt lgkmcnt(11)
    ds_read_b64 v[40:41], v2 offset:20480
    v_pk_fma_f32 v[30:31], v[30:31], s[50:51], v[48:49]
    ds_read_b32 v106, v26 offset:0
    ds_read_b32 v107, v27 offset:0
    ds_read_b64 v[42:43], v2 offset:20992
    s_waitcnt lgkmcnt(14)
    v_perm_b32 v240, v98, v96, s52
    s_waitcnt lgkmcnt(13)
    v_perm_b32 v244, v99, v97, s53
    ds_read_b32 v108, v28 offset:0
    ds_read_b32 v109, v29 offset:0
    s_waitcnt lgkmcnt(11)
    ds_read_b64 v[44:45], v2 offset:21504
    ds_read_b32 v110, v30 offset:0
    ds_read_b32 v111, v31 offset:0
    ds_read_b64 v[46:47], v2 offset:22016
    s_waitcnt lgkmcnt(14)
    v_perm_b32 v241, v102, v100, s52
    s_waitcnt lgkmcnt(13)
    v_perm_b32 v245, v103, v101, s53
    s_barrier
    v_pk_fma_f32 v[32:33], v[32:33], s[50:51], v[48:49]
    v_pk_fma_f32 v[34:35], v[34:35], s[50:51], v[48:49]
    s_waitcnt lgkmcnt(8)
    v_perm_b32 v242, v106, v104, s52
    s_waitcnt lgkmcnt(7)
    v_perm_b32 v246, v107, v105, s53
    s_waitcnt lgkmcnt(2)
    v_perm_b32 v243, v110, v108, s52
    s_waitcnt lgkmcnt(1)
    v_perm_b32 v247, v111, v109, s53
    v_pk_fma_f32 v[36:37], v[36:37], s[50:51], v[48:49]
    ds_read_b32 v96, v32 offset:0
    ds_read_b32 v97, v33 offset:0
    ds_read_b128 v[12:15], v5 offset:0
    v_pk_fma_f32 v[38:39], v[38:39], s[50:51], v[48:49]
    ds_read_b32 v98, v34 offset:0
    ds_read_b32 v99, v35 offset:0
    ds_read_b128 v[16:19], v6 offset:0
    v_pk_fma_f32 v[40:41], v[40:41], s[50:51], v[48:49]
    ds_read_b32 v100, v36 offset:0
    ds_read_b32 v101, v37 offset:0
    ds_read_b128 v[20:23], v5 offset:2048
    v_pk_fma_f32 v[42:43], v[42:43], s[50:51], v[48:49]
    ds_read_b32 v102, v38 offset:0
    ds_read_b32 v103, v39 offset:0
    ds_read_b128 v[24:27], v6 offset:2048
    v_pk_fma_f32 v[44:45], v[44:45], s[50:51], v[48:49]
    ds_read_b32 v104, v40 offset:0
    ds_read_b32 v105, v41 offset:0
    s_waitcnt lgkmcnt(11)
    ds_read_b128 v[28:31], v5 offset:4096
    v_pk_fma_f32 v[46:47], v[46:47], s[50:51], v[48:49]
    ds_read_b32 v106, v42 offset:0
    ds_read_b32 v107, v43 offset:0
    ds_read_b128 v[32:35], v6 offset:4096
    s_waitcnt lgkmcnt(14)
    v_perm_b32 v248, v98, v96, s52
    s_waitcnt lgkmcnt(13)
    v_perm_b32 v252, v99, v97, s53
    ds_read_b32 v108, v44 offset:0
    ds_read_b32 v109, v45 offset:0
    s_waitcnt lgkmcnt(11)
    ds_read_b32 v110, v46 offset:0
    ds_read_b32 v111, v47 offset:0
    s_waitcnt lgkmcnt(12)
    v_perm_b32 v249, v102, v100, s52
    s_waitcnt lgkmcnt(11)
    v_perm_b32 v253, v103, v101, s53
    s_waitcnt lgkmcnt(6)
    v_perm_b32 v250, v106, v104, s52
    s_waitcnt lgkmcnt(5)
    v_perm_b32 v254, v107, v105, s53
    s_waitcnt lgkmcnt(1)
    v_perm_b32 v251, v110, v108, s52
    s_waitcnt lgkmcnt(0)
    v_perm_b32 v255, v111, v109, s53
    s_mov_b32 s60, 2
    s_mov_b32 s56, 36864
    s_mov_b32 s57, 0xfffe5000
    s_sub_u32 s46, s36, 0
L_p2:
    s_waitcnt lgkmcnt(5)
    v_mfma_f32_16x16x32_bf16 v[96:99], v[112:115], v[12:15], 0
    ds_read_b128 v[36:39], v5 offset:6144
    v_mfma_f32_16x16x32_bf16 v[100:103], v[116:119], v[12:15], 0
    v_mfma_f32_16x16x32_bf16 v[96:99], v[120:123], v[16:19], v[96:99]
    ds_read_b128 v[40:43], v6 offset:6144
    v_mfma_f32_16x16x32_bf16 v[100:103], v[124:127], v[16:19], v[100:103]
    s_add_u32 s60, s60, 2
    s_waitcnt lgkmcnt(4)
    v_mfma_f32_16x16x32_bf16 v[96:99], v[128:131], v[20:23], v[96:99]
    ds_read_b128 v[44:47], v5 offset:8192
    v_mfma_f32_16x16x32_bf16 v[100:103], v[132:135], v[20:23], v[100:103]
    s_cmp_ge_u32 s60, 8
    v_mfma_f32_16x16x32_bf16 v[96:99], v[136:139], v[24:27], v[96:99]
    ds_read_b128 v[12:15], v6 offset:8192
    v_mfma_f32_16x16x32_bf16 v[100:103], v[140:143], v[24:27], v[100:103]
    s_cselect_b32 s61, s57, s56
    s_waitcnt lgkmcnt(4)
    v_mfma_f32_16x16x32_bf16 v[96:99], v[144:147], v[28:31], v[96:99]
    ds_read_b128 v[16:19], v5 offset:10240
    v_mfma_f32_16x16x32_bf16 v[100:103], v[148:151], v[28:31], v[100:103]
    s_and_b32 s60, s60, 7
    v_mfma_f32_16x16x32_bf16 v[96:99], v[152:155], v[32:35], v[96:99]
    ds_read_b128 v[20:23], v6 offset:10240
    v_mfma_f32_16x16x32_bf16 v[100:103], v[156:159], v[32:35], v[100:103]
    s_sub_u32 s46, s46, 1
    s_waitcnt lgkmcnt(4)
    v_mfma_f32_16x16x32_bf16 v[96:99], v[160:163], v[36:39], v[96:99]
    ds_read_b128 v[24:27], v5 offset:12288
    v_mfma_f32_16x16x32_bf16 v[100:103], v[164:167], v[36:39], v[100:103]
    s_cmp_eq_u32 s46, 0
    v_mfma_f32_16x16x32_bf16 v[96:99], v[168:171], v[40:43], v[96:99]
    ds_read_b128 v[28:31], v6 offset:12288
    v_mfma_f32_16x16x32_bf16 v[100:103], v[172:175], v[40:43], v[100:103]
    s_waitcnt lgkmcnt(4)
    v_mfma_f32_16x16x32_bf16 v[96:99], v[176:179], v[44:47], v[96:99]
    ds_read_b128 v[32:35], v5 offset:14336
    v_cvt_pk_bf16_f32 v60, v104, v108
    v_mfma_f32_16x16x32_bf16 v[100:103], v[180:183], v[44:47], v[100:103]
    v_mfma_f32_16x16x32_bf16 v[96:99], v[184:187], v[12:15], v[96:99]
    ds_read_b128 v[36:39], v6 offset:14336
    v_cvt_pk_bf16_f32 v61, v105, v109
    v_mfma_f32_16x16x32_bf16 v[100:103], v[188:191], v[12:15], v[100:103]
    s_waitcnt lgkmcnt(4)
    v_mfma_f32_16x16x32_bf16 v[96:99], v[192:195], v[16:19], v[96:99]
    ds_read_b128 v[40:43], v5 offset:16384
    v_cvt_pk_bf16_f32 v62, v106, v110
    v_mfma_f32_16x16x32_bf16 v[100:103], v[196:199], v[16:19], v[100:103]
    v_mfma_f32_16x16x32_bf16 v[96:99], v[200:203], v[20:23], v[96:99]
    ds_read_b128 v[44:47], v6 offset:16384
    v_cvt_pk_bf16_f32 v63, v107, v111
    v_mfma_f32_16x16x32_bf16 v[100:103], v[204:207], v[20:23], v[100:103]
    s_barrier
    s_waitcnt lgkmcnt(4)
    v_mfma_f32_16x16x32_bf16 v[96:99], v[208:211], v[24:27], v[96:99]
    ds_read_b128 v[12:15], v8 offset:0
    v_mfma_f32_16x16x32_bf16 v[100:103], v[212:215], v[24:27], v[100:103]
    ds_write_b64 v11, v[60:61] offset:4096
    v_mfma_f32_16x16x32_bf16 v[96:99], v[216:219], v[28:31], v[96:99]
    ds_read_b128 v[16:19], v9 offset:0
    v_mfma_f32_16x16x32_bf16 v[100:103], v[220:223], v[28:31], v[100:103]
    v_add_u32 v5, s61, v5
    s_waitcnt lgkmcnt(5)
    v_mfma_f32_16x16x32_bf16 v[96:99], v[224:227], v[32:35], v[96:99]
    ds_read_b128 v[20:23], v8 offset:2048
    v_mfma_f32_16x16x32_bf16 v[100:103], v[228:231], v[32:35], v[100:103]
    ds_write_b64 v11, v[62:63] offset:4104
    v_mfma_f32_16x16x32_bf16 v[96:99], v[232:235], v[36:39], v[96:99]
    ds_read_b128 v[24:27], v9 offset:2048
    v_mfma_f32_16x16x32_bf16 v[100:103], v[236:239], v[36:39], v[100:103]
    v_add_u32 v6, s61, v6
    s_waitcnt lgkmcnt(6)
    v_mfma_f32_16x16x32_bf16 v[96:99], v[240:243], v[40:43], v[96:99]
    ds_read_b128 v[28:31], v8 offset:4096
    v_mfma_f32_16x16x32_bf16 v[100:103], v[244:247], v[40:43], v[100:103]
    v_mfma_f32_16x16x32_bf16 v[96:99], v[248:251], v[44:47], v[96:99]
    ds_read_b128 v[32:35], v9 offset:4096
    v_mfma_f32_16x16x32_bf16 v[100:103], v[252:255], v[44:47], v[100:103]
    s_cbranch_scc1 L_exit0
    s_waitcnt lgkmcnt(5)
    v_mfma_f32_16x16x32_bf16 v[104:107], v[112:115], v[12:15], 0
    ds_read_b128 v[36:39], v8 offset:6144
    v_mfma_f32_16x16x32_bf16 v[108:111], v[116:119], v[12:15], 0
    v_mfma_f32_16x16x32_bf16 v[104:107], v[120:123], v[16:19], v[104:107]
    ds_read_b128 v[40:43], v9 offset:6144
    v_mfma_f32_16x16x32_bf16 v[108:111], v[124:127], v[16:19], v[108:111]
    s_waitcnt lgkmcnt(4)
    v_mfma_f32_16x16x32_bf16 v[104:107], v[128:131], v[20:23], v[104:107]
    ds_read_b128 v[44:47], v8 offset:8192
    v_mfma_f32_16x16x32_bf16 v[108:111], v[132:135], v[20:23], v[108:111]
    v_mfma_f32_16x16x32_bf16 v[104:107], v[136:139], v[24:27], v[104:107]
    ds_read_b128 v[12:15], v9 offset:8192
    v_mfma_f32_16x16x32_bf16 v[108:111], v[140:143], v[24:27], v[108:111]
    s_waitcnt lgkmcnt(4)
    v_mfma_f32_16x16x32_bf16 v[104:107], v[144:147], v[28:31], v[104:107]
    ds_read_b128 v[16:19], v8 offset:10240
    v_mfma_f32_16x16x32_bf16 v[108:111], v[148:151], v[28:31], v[108:111]
    v_mfma_f32_16x16x32_bf16 v[104:107], v[152:155], v[32:35], v[104:107]
    ds_read_b128 v[20:23], v9 offset:10240
    v_mfma_f32_16x16x32_bf16 v[108:111], v[156:159], v[32:35], v[108:111]
    s_sub_u32 s46, s46, 1
    s_waitcnt lgkmcnt(4)
    v_mfma_f32_16x16x32_bf16 v[104:107], v[160:163], v[36:39], v[104:107]
    ds_read_b128 v[24:27], v8 offset:12288
    v_mfma_f32_16x16x32_bf16 v[108:111], v[164:167], v[36:39], v[108:111]
    s_cmp_eq_u32 s46, 0
    v_mfma_f32_16x16x32_bf16 v[104:107], v[168:171], v[40:43], v[104:107]
    ds_read_b128 v[28:31], v9 offset:12288
    v_mfma_f32_16x16x32_bf16 v[108:111], v[172:175], v[40:43], v[108:111]
    s_waitcnt lgkmcnt(4)
    v_mfma_f32_16x16x32_bf16 v[104:107], v[176:179], v[44:47], v[104:107]
    ds_read_b128 v[32:35], v8 offset:14336
    v_cvt_pk_bf16_f32 v60, v96, v100
    v_mfma_f32_16x16x32_bf16 v[108:111], v[180:183], v[44:47], v[108:111]
    v_mfma_f32_16x16x32_bf16 v[104:107], v[184:187], v[12:15], v[104:107]
    ds_read_b128 v[36:39], v9 offset:14336
    v_cvt_pk_bf16_f32 v61, v97, v101
    v_mfma_f32_16x16x32_bf16 v[108:111], v[188:191], v[12:15], v[108:111]
    s_waitcnt lgkmcnt(4)
    v_mfma_f32_16x16x32_bf16 v[104:107], v[192:195], v[16:19], v[104:107]
    ds_read_b128 v[40:43], v8 offset:16384
    v_cvt_pk_bf16_f32 v62, v98, v102
    v_mfma_f32_16x16x32_bf16 v[108:111], v[196:199], v[16:19], v[108:111]
    v_mfma_f32_16x16x32_bf16 v[104:107], v[200:203], v[20:23], v[104:107]
    ds_read_b128 v[44:47], v9 offset:16384
    v_cvt_pk_bf16_f32 v63, v99, v103
    v_mfma_f32_16x16x32_bf16 v[108:111], v[204:207], v[20:23], v[108:111]
    s_barrier
    s_waitcnt lgkmcnt(4)
    v_mfma_f32_16x16x32_bf16 v[104:107], v[208:211], v[24:27], v[104:107]
    ds_read_b128 v[12:15], v5 offset:0
    v_mfma_f32_16x16x32_bf16 v[108:111], v[212:215], v[24:27], v[108:111]
    ds_write_b64 v11, v[60:61] offset:0
    v_mfma_f32_16x16x32_bf16 v[104:107], v[216:219], v[28:31], v[104:107]
    ds_read_b128 v[16:19], v6 offset:0
    v_mfma_f32_16x16x32_bf16 v[108:111], v[220:223], v[28:31], v[108:111]
    v_add_u32 v8, s61, v8
    s_waitcnt lgkmcnt(5)
    v_mfma_f32_16x16x32_bf16 v[104:107], v[224:227], v[32:35], v[104:107]
    ds_read_b128 v[20:23], v5 offset:2048
    v_mfma_f32_16x16x32_bf16 v[108:111], v[228:231], v[32:35], v[108:111]
    ds_write_b64 v11, v[62:63] offset:8
    v_mfma_f32_16x16x32_bf16 v[104:107], v[232:235], v[36:39], v[104:107]
    ds_read_b128 v[24:27], v6 offset:2048
    v_mfma_f32_16x16x32_bf16 v[108:111], v[236:239], v[36:39], v[108:111]
    v_add_u32 v9, s61, v9
    s_waitcnt lgkmcnt(6)
    v_mfma_f32_16x16x32_bf16 v[104:107], v[240:243], v[40:43], v[104:107]
    ds_read_b128 v[28:31], v5 offset:4096
    v_mfma_f32_16x16x32_bf16 v[108:111], v[244:247], v[40:43], v[108:111]
    v_mfma_f32_16x16x32_bf16 v[104:107], v[248:251], v[44:47], v[104:107]
    ds_read_b128 v[32:35], v6 offset:4096
    v_mfma_f32_16x16x32_bf16 v[108:111], v[252:255], v[44:47], v[108:111]
    s_cbranch_scc0 L_p2
    s_nop 7
    v_cvt_pk_bf16_f32 v60, v104, v108
    v_cvt_pk_bf16_f32 v61, v105, v109
    v_cvt_pk_bf16_f32 v62, v106, v110
    v_cvt_pk_bf16_f32 v63, v107, v111
    ds_write_b128 v11, v[60:63] offset:4096
    s_waitcnt lgkmcnt(0)
    s_barrier
    s_endpgm
L_exit0:
    s_nop 7
    v_cvt_pk_bf16_f32 v60, v96, v100
    v_cvt_pk_bf16_f32 v61, v97, v101
    v_cvt_pk_bf16_f32 v62, v98, v102
    v_cvt_pk_bf16_f32 v63, v99, v103
    ds_write_b128 v11, v[60:63] offset:0
    s_waitcnt lgkmcnt(0)
    s_barrier
L_exit:
    s_endpgm
.section .rodata,"a"
.p2align 6
.amdhsa_kernel standalone__normalfloat_lut_codebook_lookup__prompt_kernel
  .amdhsa_next_free_vgpr 256
  .amdhsa_next_free_sgpr 64
  .amdhsa_accum_offset 256
  .amdhsa_group_segment_fixed_size 0
  .amdhsa_kernarg_size 56
  .amdhsa_user_sgpr_count 2
  .amdhsa_user_sgpr_kernarg_segment_ptr 1
  .amdhsa_system_sgpr_workgroup_id_x 1
  .amdhsa_float_denorm_mode_32 3
.end_amdhsa_kernel
```
